```python
import torch

def _softmax(x, axis=-1):
    return torch.softmax(x, dim=axis)
def _gelu(x):
    return torch.nn.functional.gelu(x, approximate="tanh")
def _silu(x):
    return torch.nn.functional.silu(x)
def _sigmoid(x):
    return torch.sigmoid(x)
def _layernorm(x, axis=-1, eps=1e-5):
    m = x.mean(dim=axis, keepdim=True)
    v = x.var(dim=axis, keepdim=True, unbiased=False)
    return (x - m) / torch.sqrt(v + eps)
def _scatter_add(tgt, idx, src, axis=0):
    return tgt.clone().index_add_(axis, idx, src)
def _segment_sum(src, seg, n):
    out = torch.zeros((n,) + src.shape[1:], dtype=src.dtype)
    return out.index_add_(0, seg, src)
def _pad(x, pw):
    flat = tuple(v for pair in reversed(pw) for v in pair)
    return torch.nn.functional.pad(x, flat)

kernel_name = 'standalone__batchnorm__prompt'

def setup_inputs():

    _w = (lambda a: (lambda t: t.to(torch.bfloat16) if t.is_floating_point() else t)(torch.as_tensor(a)))
    B, S, C = 2, 2048, 448
    K = 3
    return {
        "x": _w((lambda *s: torch.randn(*s, dtype=torch.bfloat16) * 0.05)(B, S, C)),
        "w": _w((lambda *s: torch.randn(*s, dtype=torch.bfloat16) * 0.05)(K, C, C) * (1.0 / (K * C) ** 0.5)),
        "mean": _w((lambda *s: torch.randn(*s, dtype=torch.bfloat16) * 0.05)(C) * 0.1),
        "var": _w(torch.abs((lambda *s: torch.randn(*s, dtype=torch.bfloat16) * 0.05)(C)) + 0.5),
        "g": _w((lambda *s: torch.randn(*s, dtype=torch.bfloat16) * 0.05)(C) + 1.0),
        "b": _w((lambda *s: torch.randn(*s, dtype=torch.bfloat16) * 0.05)(C) * 0.1),
    }

def reference(x, w, mean, var, g, b):
    K = 3
    P = K // 2
    S = x.shape[1]
    xp = _pad(x, ((0, 0), (P, P), (0, 0)))
    y = sum(torch.einsum('bsc,cd->bsd', xp[:, k:k + S, :], w[k]) for k in range(K))
    inv_std = 1.0 / torch.sqrt(var + 1e-5)
    y = (y - mean) * (g * inv_std) + b
    return _silu(y)
```

```asm
; @launch grid=(256,1,1) block=(512,1,1) lds=158976
.amdgcn_target "amdgcn-amd-amdhsa--gfx950"
.text
.globl standalone__batchnorm__prompt_kernel
.p2alignl 12, 0xbf810000
.fill 0x340, 4, 0xbf810000
.p2align 8
.type standalone__batchnorm__prompt_kernel,@function
standalone__batchnorm__prompt_kernel:
    s_load_dwordx16 s[4:19], s[0:1], 0
    s_cmp_ge_u32 s2, 256
    s_cbranch_scc1 L_exit
    v_lshrrev_b32 v1, 6, v0
    v_and_b32 v0, 63, v0
    v_readfirstlane_b32 s28, v1
    s_and_b32 s31, s2, 7
    s_lshl_b32 s31, s31, 2
    s_lshr_b32 s89, 0x6543210, s31
    s_and_b32 s89, s89, 7
    s_lshl_b32 s88, s89, 7
    s_bfe_u32 s32, s2, 0x20003
    s_add_u32 s35, s31, s32
    s_lshl_b32 s29, s35, 7
    s_movk_i32 s87, 896
    s_mov_b32 s23, 0x20000
    s_lshr_b32 s30, s2, 5
    s_sub_u32 s30, s30, 1
    s_cbranch_scc0 L_main
    s_cmp_eq_u32 s28, 0
    s_cbranch_scc1 L_warm
    s_cmp_lg_u32 s28, 1
    s_cbranch_scc1 L_exit
    s_getpc_b64 s[24:25]
L_pc:
    v_min_u32 v1, 20, v0
    s_mul_i32 s32, s32, 21
    v_add_lshl_u32 v1, v1, s32, 7
    v_min_u32 v1, L_end - L_pc - 0x400, v1
    v_mov_b32 v3, s25
    v_add_co_u32 v2, vcc, s24, v1
    s_nop 1
    v_addc_co_u32 v3, vcc, 0, v3, vcc
    global_load_dword v4, v[2:3], off offset:1024
L_exit:
    s_endpgm
L_warm:
    s_waitcnt lgkmcnt(0)
    v_add_u32 v1, s29, v0
    v_mul_u32_u24 v4, s87, v1
    v_lshrrev_b32 v9, 3, v0
    v_mul_u32_u24 v1, 129, v9
    v_add_u32 v1, s29, v1
    v_mul_u32_u24 v1, s87, v1
    v_and_b32 v2, 7, v0
    v_min_u32 v2, 6, v2
    v_lshl_add_u32 v1, v2, 7, v1
    v_subrev_u32 v5, s87, v1
    v_bfrev_b32 v8, 1
    v_cmp_gt_u32 vcc, 16, v0
    s_mov_b32 s22, 3670016
    s_lshl_b32 s33, s87, 6
    v_cndmask_b32 v5, v8, v5, vcc
    v_subrev_u32 v7, 32, v0
    v_cmp_gt_u32 vcc, 19, v7
    s_sub_u32 s31, s35, 4
    s_mul_i32 s31, s31, 19
    v_add_u32 v1, s31, v7
    v_mul_i32_i24 v1, s87, v1
    v_cndmask_b32 v5, v5, v1, vcc
    v_add_u32 v3, s33, v4
    s_mov_b64 s[20:21], s[4:5]
    buffer_load_dword v10, v5, s[20:23], 0 offen
    s_addk_i32 s88, 128
    s_cmpk_eq_u32 s88, 896
    s_cselect_b32 s88, 0, s88
    buffer_load_dword v11, v4, s[20:23], s88 offen
    buffer_load_dword v12, v3, s[20:23], s88 offen
    s_branch L_warm2
L_main:
    s_lshl_b32 s30, s30, 7
    s_cmp_lt_u32 s28, 4
    s_cbranch_scc1 L_loader
    v_mov_b32 v44, 0
    s_cmp_eq_u32 s28, 5
    s_cbranch_scc1 L_pg0
    s_branch L_consumer
L_loader:
    s_setprio 2
    v_lshrrev_b32 v1, 3, v0
    v_lshrrev_b32 v2, 5, v0
    v_xor_b32 v2, v1, v2
    s_lshl_b32 s31, s28, 3
    v_add_u32 v2, s31, v2
    v_mul_u32_u24 v2, s87, v2
    v_and_b32 v3, 7, v0
    s_lshl_b32 s32, s28, 1
    v_xor_b32 v7, s32, v3
    v_lshl_add_u32 v4, v7, 4, v2
    v_add_u32 v2, s31, v1
    v_mul_u32_u24 v2, s87, v2
    v_and_b32 v1, 2, v1
    v_xor_b32 v3, v1, v3
    s_and_b32 s32, s28, 1
    s_lshl_b32 s32, s32, 2
    v_xor_b32 v3, s32, v3
    v_lshl_add_u32 v13, v3, 4, v2
    s_and_b32 s31, s35, 15
    s_cselect_b32 s32, 0, s87
    v_cmp_gt_u32 vcc, s32, v4
    v_bfrev_b32 v1, 1
    s_cmp_eq_u32 s31, 15
    s_cselect_b32 s32, s87, 0
    v_cndmask_b32 v8, v4, v1, vcc
    s_sub_u32 s22, 116480, s32
    s_mov_b32 s27, s23
    s_sub_u32 s26, 1204224, s30
    s_mul_i32 s31, s29, s87
    s_sub_u32 s31, s31, s87
    s_ashr_i32 s32, s31, 31
    s_lshl_b32 s34, s28, 10
    s_movk_i32 s33, 28672
    v_add_u32 v9, s33, v4
    v_add_u32 v10, s33, v9
    v_add_u32 v11, s33, v10
    v_add_u32 v12, s33, v11
    s_mul_i32 s33, s33, 14
    v_add_u32 v14, s33, v13
    v_add_u32 v15, s33, v14
    v_and_b32 v1, 31, v0
    v_lshl_add_u32 v16, v1, 2, s30
    s_and_b32 s90, s35, 3
    s_lshl2_add_u32 s90, s90, s28
    s_mul_i32 s90, s90, 1792
    s_add_u32 s90, s90, s33
    s_mul_i32 s33, s88, 448
    s_add_u32 s90, s90, s33
    s_cmp_eq_u32 s28, 0
    s_cselect_b64 vcc, -1, 0
    s_add_u32 m0, s34, 86016
    s_waitcnt lgkmcnt(0)
    s_add_u32 s20, s4, s31
    s_addc_u32 s21, s5, s32
    buffer_load_dwordx4 v8, s[20:23], s88 offen lds
    s_add_u32 s24, s6, s30
    s_addc_u32 s25, s7, 0
    s_add_u32 s90, s24, s90
    s_addc_u32 s91, s25, 0
    s_addk_i32 m0, 4096
    s_nop 0
    buffer_load_dwordx4 v9, s[20:23], s88 offen lds
    s_addk_i32 m0, 4096
    s_nop 0
    buffer_load_dwordx4 v10, s[20:23], s88 offen lds
    s_addk_i32 m0, 8192
    s_cbranch_vccz L_sk1
    buffer_load_dwordx4 v12, s[20:23], s88 offen lds
L_sk1:
    s_addk_i32 m0, -4096
    s_load_dword s3, s[90:91], -372736
    buffer_load_dwordx4 v11, s[20:23], s88 offen lds
    s_load_dword s3, s[90:91], -372672
    s_load_dword s3, s[90:91], -371840
    s_add_u32 m0, s34, 0
    s_load_dword s3, s[90:91], -371776
    buffer_load_dwordx4 v13, s[24:27], s33 offen lds
    s_load_dword s3, s[90:91], 28672
    s_load_dword s3, s[90:91], 28736
    s_addk_i32 m0, 4096
    s_load_dword s3, s[90:91], 29568
    buffer_load_dwordx4 v14, s[24:27], s33 offen lds
    s_load_dword s3, s[90:91], 29632
    s_load_dword s3, s[90:91], 430080
    s_addk_i32 m0, 4096
    s_load_dword s3, s[90:91], 430144
    buffer_load_dwordx4 v15, s[24:27], s33 offen lds
    s_load_dword s3, s[90:91], 430976
    s_load_dword s3, s[90:91], 431040
    s_bitcmp1_b32 s28, 0
    s_cselect_b64 s[8:9], s[10:11], s[8:9]
    s_cselect_b64 s[12:13], s[14:15], s[12:13]
    s_add_u32 m0, s34, 155648
    s_bitcmp1_b32 s28, 1
    s_cselect_b64 s[96:97], s[12:13], s[8:9]
    global_load_lds_dword v16, s[96:97]
    s_add_u32 m0, s34, 12288
    s_addk_i32 s33, 28672
    buffer_load_dwordx4 v13, s[24:27], s33 offen lds
    s_addk_i32 m0, 4096
    s_nop 0
    buffer_load_dwordx4 v14, s[24:27], s33 offen lds
    s_addk_i32 m0, 4096
    s_nop 0
    buffer_load_dwordx4 v15, s[24:27], s33 offen lds
    s_addk_i32 s88, 128
    s_cmpk_eq_u32 s88, 896
    s_cselect_b32 s88, 0, s88
    s_add_u32 m0, s34, 103424
    s_nop 0
    buffer_load_dwordx4 v8, s[20:23], s88 offen lds
    s_addk_i32 m0, 4096
    s_nop 0
    buffer_load_dwordx4 v9, s[20:23], s88 offen lds
    s_addk_i32 m0, 4096
    s_nop 0
    buffer_load_dwordx4 v10, s[20:23], s88 offen lds
    s_addk_i32 m0, 8192
    s_cbranch_vccz L_sk2
    buffer_load_dwordx4 v12, s[20:23], s88 offen lds
L_sk2:
    s_addk_i32 m0, -4096
    s_nop 0
    buffer_load_dwordx4 v11, s[20:23], s88 offen lds
    s_add_u32 m0, s34, 24576
    s_mul_i32 s33, s88, 448
    buffer_load_dwordx4 v13, s[24:27], s33 offen lds
    s_addk_i32 m0, 4096
    s_nop 0
    buffer_load_dwordx4 v14, s[24:27], s33 offen lds
    s_addk_i32 m0, 4096
    s_nop 0
    buffer_load_dwordx4 v15, s[24:27], s33 offen lds
    s_waitcnt vmcnt(11)
    s_barrier
    s_addk_i32 m0, 4096
    s_addk_i32 s33, 28672
    buffer_load_dwordx4 v13, s[24:27], s33 offen lds
    s_addk_i32 m0, 4096
    s_nop 0
    buffer_load_dwordx4 v14, s[24:27], s33 offen lds
    s_addk_i32 m0, 4096
    s_nop 0
    buffer_load_dwordx4 v15, s[24:27], s33 offen lds
    s_addk_i32 s88, 128
    s_cmpk_eq_u32 s88, 896
    s_cselect_b32 s88, 0, s88
    s_add_u32 m0, s34, 120832
    s_nop 0
    buffer_load_dwordx4 v8, s[20:23], s88 offen lds
    s_waitcnt vmcnt(11)
    s_barrier
    s_addk_i32 m0, 4096
    s_nop 0
    buffer_load_dwordx4 v9, s[20:23], s88 offen lds
    s_addk_i32 m0, 4096
    s_nop 0
    buffer_load_dwordx4 v10, s[20:23], s88 offen lds
    s_addk_i32 m0, 8192
    s_cbranch_vccz L_sk3
    buffer_load_dwordx4 v12, s[20:23], s88 offen lds
L_sk3:
    s_addk_i32 m0, -4096
    s_nop 0
    buffer_load_dwordx4 v11, s[20:23], s88 offen lds
    s_add_u32 m0, s34, 49152
    s_mul_i32 s33, s88, 448
    buffer_load_dwordx4 v13, s[24:27], s33 offen lds
    s_addk_i32 m0, 4096
    s_nop 0
    buffer_load_dwordx4 v14, s[24:27], s33 offen lds
    s_addk_i32 m0, 4096
    s_nop 0
    buffer_load_dwordx4 v15, s[24:27], s33 offen lds
    s_waitcnt vmcnt(10)
    s_barrier
    s_addk_i32 m0, 4096
    s_addk_i32 s33, 28672
    buffer_load_dwordx4 v13, s[24:27], s33 offen lds
    s_addk_i32 m0, 4096
    s_nop 0
    buffer_load_dwordx4 v14, s[24:27], s33 offen lds
    s_addk_i32 m0, 4096
    s_nop 0
    buffer_load_dwordx4 v15, s[24:27], s33 offen lds
    s_addk_i32 s88, 128
    s_cmpk_eq_u32 s88, 896
    s_cselect_b32 s88, 0, s88
    s_add_u32 m0, s34, 138240
    s_nop 0
    buffer_load_dwordx4 v8, s[20:23], s88 offen lds
    s_addk_i32 m0, 4096
    s_nop 0
    buffer_load_dwordx4 v9, s[20:23], s88 offen lds
    s_waitcnt vmcnt(12)
    s_barrier
    s_addk_i32 m0, 4096
    s_nop 0
    buffer_load_dwordx4 v10, s[20:23], s88 offen lds
    s_addk_i32 m0, 8192
    s_cbranch_vccz L_sk4
    buffer_load_dwordx4 v12, s[20:23], s88 offen lds
L_sk4:
    s_addk_i32 m0, -4096
    s_nop 0
    buffer_load_dwordx4 v11, s[20:23], s88 offen lds
    s_add_u32 m0, s34, 73728
    s_mul_i32 s33, s88, 448
    buffer_load_dwordx4 v13, s[24:27], s33 offen lds
    s_addk_i32 m0, 4096
    s_nop 0
    buffer_load_dwordx4 v14, s[24:27], s33 offen lds
    s_addk_i32 m0, 4096
    s_nop 0
    buffer_load_dwordx4 v15, s[24:27], s33 offen lds
    s_waitcnt vmcnt(10)
    s_barrier
    s_add_u32 m0, s34, 0
    s_addk_i32 s33, 28672
    buffer_load_dwordx4 v13, s[24:27], s33 offen lds
    s_addk_i32 m0, 4096
    s_nop 0
    buffer_load_dwordx4 v14, s[24:27], s33 offen lds
    s_addk_i32 m0, 4096
    s_nop 0
    buffer_load_dwordx4 v15, s[24:27], s33 offen lds
    s_addk_i32 s88, 128
    s_cmpk_eq_u32 s88, 896
    s_cselect_b32 s88, 0, s88
    s_add_u32 m0, s34, 86016
    s_nop 0
    buffer_load_dwordx4 v8, s[20:23], s88 offen lds
    s_addk_i32 m0, 4096
    s_nop 0
    buffer_load_dwordx4 v9, s[20:23], s88 offen lds
    s_waitcnt vmcnt(12)
    s_barrier
    s_addk_i32 m0, 4096
    s_nop 0
    buffer_load_dwordx4 v10, s[20:23], s88 offen lds
    s_addk_i32 m0, 8192
    s_cbranch_vccz L_sk5
    buffer_load_dwordx4 v12, s[20:23], s88 offen lds
L_sk5:
    s_addk_i32 m0, -4096
    s_nop 0
    buffer_load_dwordx4 v11, s[20:23], s88 offen lds
    s_add_u32 m0, s34, 12288
    s_mul_i32 s33, s88, 448
    buffer_load_dwordx4 v13, s[24:27], s33 offen lds
    s_addk_i32 m0, 4096
    s_nop 0
    buffer_load_dwordx4 v14, s[24:27], s33 offen lds
    s_addk_i32 m0, 4096
    s_nop 0
    buffer_load_dwordx4 v15, s[24:27], s33 offen lds
    s_waitcnt vmcnt(10)
    s_setprio 0
    s_barrier
    s_addk_i32 m0, 4096
    s_addk_i32 s33, 28672
    buffer_load_dwordx4 v13, s[24:27], s33 offen lds
    s_addk_i32 m0, 4096
    s_nop 0
    buffer_load_dwordx4 v14, s[24:27], s33 offen lds
    s_addk_i32 m0, 4096
    s_nop 0
    buffer_load_dwordx4 v15, s[24:27], s33 offen lds
    s_addk_i32 s88, 128
    s_cmpk_eq_u32 s88, 896
    s_cselect_b32 s88, 0, s88
    s_add_u32 m0, s34, 103424
    s_nop 0
    buffer_load_dwordx4 v8, s[20:23], s88 offen lds
    s_addk_i32 m0, 4096
    s_nop 0
    buffer_load_dwordx4 v9, s[20:23], s88 offen lds
    s_waitcnt vmcnt(12)
    s_barrier
    s_addk_i32 m0, 4096
    s_nop 0
    buffer_load_dwordx4 v10, s[20:23], s88 offen lds
    s_addk_i32 m0, 8192
    s_cbranch_vccz L_sk6
    buffer_load_dwordx4 v12, s[20:23], s88 offen lds
L_sk6:
    s_addk_i32 m0, -4096
    s_nop 0
    buffer_load_dwordx4 v11, s[20:23], s88 offen lds
    s_add_u32 m0, s34, 36864
    s_mul_i32 s33, s88, 448
    buffer_load_dwordx4 v13, s[24:27], s33 offen lds
    s_addk_i32 m0, 4096
    s_nop 0
    buffer_load_dwordx4 v14, s[24:27], s33 offen lds
    s_addk_i32 m0, 4096
    s_nop 0
    buffer_load_dwordx4 v15, s[24:27], s33 offen lds
    s_waitcnt vmcnt(10)
    s_barrier
    s_addk_i32 m0, 4096
    s_addk_i32 s33, 28672
    buffer_load_dwordx4 v13, s[24:27], s33 offen lds
    s_addk_i32 m0, 4096
    s_nop 0
    buffer_load_dwordx4 v14, s[24:27], s33 offen lds
    s_addk_i32 m0, 4096
    s_nop 0
    buffer_load_dwordx4 v15, s[24:27], s33 offen lds
    s_addk_i32 s88, 128
    s_cmpk_eq_u32 s88, 896
    s_cselect_b32 s88, 0, s88
    s_add_u32 m0, s34, 120832
    s_nop 0
    buffer_load_dwordx4 v8, s[20:23], s88 offen lds
    s_addk_i32 m0, 4096
    s_nop 0
    buffer_load_dwordx4 v9, s[20:23], s88 offen lds
    s_waitcnt vmcnt(12)
    s_barrier
    s_addk_i32 m0, 4096
    s_nop 0
    buffer_load_dwordx4 v10, s[20:23], s88 offen lds
    s_addk_i32 m0, 8192
    s_cbranch_vccz L_sk7
    buffer_load_dwordx4 v12, s[20:23], s88 offen lds
L_sk7:
    s_addk_i32 m0, -4096
    s_nop 0
    buffer_load_dwordx4 v11, s[20:23], s88 offen lds
    s_add_u32 m0, s34, 61440
    s_mul_i32 s33, s88, 448
    buffer_load_dwordx4 v13, s[24:27], s33 offen lds
    s_addk_i32 m0, 4096
    s_nop 0
    buffer_load_dwordx4 v14, s[24:27], s33 offen lds
    s_addk_i32 m0, 4096
    s_nop 0
    buffer_load_dwordx4 v15, s[24:27], s33 offen lds
    s_waitcnt vmcnt(10)
    s_barrier
    s_addk_i32 m0, 4096
    s_addk_i32 s33, 28672
    buffer_load_dwordx4 v13, s[24:27], s33 offen lds
    s_addk_i32 m0, 4096
    s_nop 0
    buffer_load_dwordx4 v14, s[24:27], s33 offen lds
    s_addk_i32 m0, 4096
    s_nop 0
    buffer_load_dwordx4 v15, s[24:27], s33 offen lds
    s_waitcnt vmcnt(10)
    s_barrier
    s_waitcnt vmcnt(3)
    s_barrier
    s_waitcnt vmcnt(0)
    s_barrier
    s_endpgm
L_warm2:
    s_addk_i32 s88, 128
    s_cmpk_eq_u32 s88, 896
    s_cselect_b32 s88, 0, s88
    buffer_load_dword v13, v4, s[20:23], s88 offen
    buffer_load_dword v14, v3, s[20:23], s88 offen
    s_addk_i32 s88, 256
    s_sub_u32 s31, s88, s87
    s_cselect_b32 s88, s88, s31
    buffer_load_dword v15, v4, s[20:23], s88 offen
    buffer_load_dword v16, v3, s[20:23], s88 offen
    s_addk_i32 s88, 128
    s_cmpk_eq_u32 s88, 896
    s_cselect_b32 s88, 0, s88
    buffer_load_dword v17, v4, s[20:23], s88 offen
    buffer_load_dword v18, v3, s[20:23], s88 offen
    s_addk_i32 s88, 128
    s_cmpk_eq_u32 s88, 896
    s_cselect_b32 s88, 0, s88
    buffer_load_dword v19, v4, s[20:23], s88 offen
    buffer_load_dword v20, v3, s[20:23], s88 offen
    s_endpgm
.p2alignl 12, 0xbf810000
L_consumer:
    s_setprio 1
    s_and_b32 s31, s28, 1
    s_bfe_u32 s32, s28, 0x10001
    v_and_b32 v1, 15, v0
    v_lshrrev_b32 v2, 4, v0
    s_lshl_b32 s33, s31, 6
    s_add_u32 s33, s33, s30
    s_lshl_b32 s34, s32, 6
    s_add_u32 s34, s34, s29
    v_and_b32 v4, 60, v0
    v_add_u32 v4, s34, v4
    v_mul_u32_u24 v4, 896, v4
    v_and_b32 v3, 3, v0
    v_lshl_add_u32 v5, v3, 4, s33
    v_add_u32 v44, v4, v5
    s_and_b32 s34, s28, 3
    s_lshl_b32 s34, s34, 12
    v_bfe_u32 v4, v0, 3, 2
    v_xor_b32 v4, v4, v0
    v_lshl_add_u32 v47, v4, 4, s34
    v_bfe_u32 v4, v0, 1, 2
    v_lshrrev_b32 v5, 1, v2
    v_xor_b32 v4, v4, v5
    v_lshl_add_u32 v4, v1, 2, v4
    v_lshl_add_u32 v4, v4, 4, s34
    v_and_b32 v5, 1, v2
    v_lshl_add_u32 v45, v5, 3, v4
    v_xor_b32 v46, 32, v45
    s_lshl_b32 s32, s32, 4
    v_add_u32 v4, s32, v1
    v_lshlrev_b32 v7, 4, v2
    v_and_b32 v5, 1, v4
    v_lshlrev_b32 v5, 7, v5
    v_and_b32 v6, 6, v4
    v_lshl_add_u32 v5, v6, 4, v5
    v_xor_b32 v5, v5, v7
    v_lshl_add_u32 v5, v4, 9, v5
    v_add_u32 v32, 86016, v5
    v_xor_b32 v33, 64, v32
    v_xor_b32 v34, 128, v32
    v_xor_b32 v35, 192, v32
    v_add_u32 v4, 1, v4
    v_and_b32 v5, 1, v4
    v_lshlrev_b32 v5, 7, v5
    v_and_b32 v6, 6, v4
    v_lshl_add_u32 v5, v6, 4, v5
    v_xor_b32 v5, v5, v7
    v_lshl_add_u32 v5, v4, 9, v5
    v_add_u32 v36, 86016, v5
    v_xor_b32 v37, 64, v36
    v_xor_b32 v38, 128, v36
    v_xor_b32 v39, 192, v36
    v_lshrrev_b32 v4, 2, v1
    v_lshl_add_u32 v5, v2, 3, v4
    v_lshlrev_b32 v5, 7, v5
    v_and_b32 v6, 1, v0
    v_lshl_add_u32 v5, v6, 3, v5
    v_bfe_u32 v6, v0, 1, 1
    s_lshl_b32 s31, s31, 2
    v_or_b32 v6, s31, v6
    v_and_b32 v4, 2, v4
    v_xor_b32 v6, v6, v4
    v_and_b32 v4, 1, v2
    v_lshlrev_b32 v4, 2, v4
    v_xor_b32 v6, v6, v4
    v_lshl_add_u32 v40, v6, 4, v5
    v_xor_b32 v41, 32, v40
    v_add_u32 v42, 49152, v40
    v_add_u32 v43, 49152, v41
    s_lshl_b32 s31, s31, 4
    s_add_u32 s31, s31, 155648
    v_and_b32 v4, 4, v0
    v_add_u32 v4, v4, v2
    v_lshl_add_u32 v4, v4, 2, v3
    v_lshl_add_u32 v49, v4, 1, s31
    s_mov_b32 s32, 0x3fb8aa3b
    s_mov_b32 s33, 0x3fb8aa3b
    s_cmp_eq_u32 s32, 0
    s_waitcnt lgkmcnt(0)
    s_barrier
    ds_read_b64_tr_b16 v[52:53], v40 offset:0
    ds_read_b64_tr_b16 v[54:55], v40 offset:512
    ds_read_b128 v[56:59], v32 offset:0
    ds_read_b128 v[60:63], v34 offset:0
    ds_read_b128 v[64:67], v32 offset:256
    ds_read_b128 v[68:71], v34 offset:256
    ds_read_b64_tr_b16 v[72:73], v41 offset:0
    ds_read_b64_tr_b16 v[74:75], v41 offset:512
    s_waitcnt lgkmcnt(5)
    v_mfma_f32_16x16x32_bf16 v[0:3], v[52:55], v[56:59], 0
    s_waitcnt lgkmcnt(4)
    ds_read_b64_tr_b16 v[76:77], v40 offset:4096
    ds_read_b64_tr_b16 v[78:79], v40 offset:4608
    v_mfma_f32_16x16x32_bf16 v[8:11], v[52:55], v[60:63], 0
    s_waitcnt lgkmcnt(5)
    ds_read_b64_tr_b16 v[80:81], v40 offset:8192
    v_mfma_f32_16x16x32_bf16 v[16:19], v[52:55], v[64:67], 0
    s_waitcnt lgkmcnt(5)
    ds_read_b64_tr_b16 v[82:83], v40 offset:8704
    v_mfma_f32_16x16x32_bf16 v[24:27], v[52:55], v[68:71], 0
    s_waitcnt lgkmcnt(4)
    ds_read_b128 v[84:87], v36 offset:0
    v_mfma_f32_16x16x32_bf16 v[4:7], v[72:75], v[56:59], 0
    ds_read_b128 v[88:91], v38 offset:0
    v_mfma_f32_16x16x32_bf16 v[12:15], v[72:75], v[60:63], 0
    ds_read_b64_tr_b16 v[92:93], v41 offset:4096
    v_mfma_f32_16x16x32_bf16 v[20:23], v[72:75], v[64:67], 0
    ds_read_b64_tr_b16 v[94:95], v41 offset:4608
    v_mfma_f32_16x16x32_bf16 v[28:31], v[72:75], v[68:71], 0
    s_waitcnt lgkmcnt(6)
    ds_read_b64_tr_b16 v[96:97], v41 offset:8192
    v_mfma_f32_16x16x32_bf16 v[0:3], v[76:79], v[60:63], v[0:3]
    s_waitcnt lgkmcnt(5)
    ds_read_b64_tr_b16 v[98:99], v41 offset:8704
    v_mfma_f32_16x16x32_bf16 v[0:3], v[80:83], v[64:67], v[0:3]
    v_mfma_f32_16x16x32_bf16 v[8:11], v[76:79], v[64:67], v[8:11]
    v_mfma_f32_16x16x32_bf16 v[8:11], v[80:83], v[68:71], v[8:11]
    v_mfma_f32_16x16x32_bf16 v[16:19], v[76:79], v[68:71], v[16:19]
    s_waitcnt lgkmcnt(5)
    v_mfma_f32_16x16x32_bf16 v[16:19], v[80:83], v[84:87], v[16:19]
    s_barrier
    v_mfma_f32_16x16x32_bf16 v[24:27], v[76:79], v[84:87], v[24:27]
    s_waitcnt lgkmcnt(4)
    ds_read_b64_tr_b16 v[100:101], v40 offset:12288
    v_mfma_f32_16x16x32_bf16 v[24:27], v[80:83], v[88:91], v[24:27]
    s_waitcnt lgkmcnt(3)
    ds_read_b64_tr_b16 v[102:103], v40 offset:12800
    v_mfma_f32_16x16x32_bf16 v[4:7], v[92:95], v[60:63], v[4:7]
    s_waitcnt lgkmcnt(2)
    ds_read_b128 v[104:107], v33 offset:0
    v_mfma_f32_16x16x32_bf16 v[4:7], v[96:99], v[64:67], v[4:7]
    ds_read_b128 v[108:111], v35 offset:0
    v_mfma_f32_16x16x32_bf16 v[12:15], v[92:95], v[64:67], v[12:15]
    ds_read_b128 v[112:115], v33 offset:256
    v_mfma_f32_16x16x32_bf16 v[12:15], v[96:99], v[68:71], v[12:15]
    ds_read_b128 v[116:119], v35 offset:256
    v_mfma_f32_16x16x32_bf16 v[20:23], v[92:95], v[68:71], v[20:23]
    ds_read_b64_tr_b16 v[120:121], v41 offset:12288
    v_mfma_f32_16x16x32_bf16 v[20:23], v[96:99], v[84:87], v[20:23]
    ds_read_b64_tr_b16 v[122:123], v41 offset:12800
    v_mfma_f32_16x16x32_bf16 v[28:31], v[92:95], v[84:87], v[28:31]
    ds_read_b64_tr_b16 v[124:125], v40 offset:16384
    v_mfma_f32_16x16x32_bf16 v[28:31], v[96:99], v[88:91], v[28:31]
    s_waitcnt lgkmcnt(6)
    ds_read_b64_tr_b16 v[126:127], v40 offset:16896
    v_mfma_f32_16x16x32_bf16 v[0:3], v[100:103], v[104:107], v[0:3]
    s_waitcnt lgkmcnt(6)
    ds_read_b64_tr_b16 v[128:129], v40 offset:20480
    v_mfma_f32_16x16x32_bf16 v[8:11], v[100:103], v[108:111], v[8:11]
    s_waitcnt lgkmcnt(6)
    ds_read_b64_tr_b16 v[130:131], v40 offset:20992
    v_mfma_f32_16x16x32_bf16 v[16:19], v[100:103], v[112:115], v[16:19]
    s_waitcnt lgkmcnt(6)
    ds_read_b128 v[132:135], v37 offset:0
    v_mfma_f32_16x16x32_bf16 v[24:27], v[100:103], v[116:119], v[24:27]
    s_waitcnt lgkmcnt(5)
    ds_read_b128 v[136:139], v39 offset:0
    v_mfma_f32_16x16x32_bf16 v[4:7], v[120:123], v[104:107], v[4:7]
    ds_read_b64_tr_b16 v[140:141], v41 offset:16384
    v_mfma_f32_16x16x32_bf16 v[12:15], v[120:123], v[108:111], v[12:15]
    ds_read_b64_tr_b16 v[142:143], v41 offset:16896
    v_mfma_f32_16x16x32_bf16 v[20:23], v[120:123], v[112:115], v[20:23]
    ds_read_b64_tr_b16 v[144:145], v41 offset:20480
    v_mfma_f32_16x16x32_bf16 v[28:31], v[120:123], v[116:119], v[28:31]
    s_waitcnt lgkmcnt(7)
    ds_read_b64_tr_b16 v[146:147], v41 offset:20992
    v_mfma_f32_16x16x32_bf16 v[0:3], v[124:127], v[108:111], v[0:3]
    s_waitcnt lgkmcnt(6)
    v_mfma_f32_16x16x32_bf16 v[0:3], v[128:131], v[112:115], v[0:3]
    v_mfma_f32_16x16x32_bf16 v[8:11], v[124:127], v[112:115], v[8:11]
    v_mfma_f32_16x16x32_bf16 v[8:11], v[128:131], v[116:119], v[8:11]
    v_mfma_f32_16x16x32_bf16 v[16:19], v[124:127], v[116:119], v[16:19]
    s_waitcnt lgkmcnt(5)
    v_mfma_f32_16x16x32_bf16 v[16:19], v[128:131], v[132:135], v[16:19]
    s_barrier
    v_mfma_f32_16x16x32_bf16 v[24:27], v[124:127], v[132:135], v[24:27]
    s_waitcnt lgkmcnt(3)
    ds_read_b64_tr_b16 v[148:149], v40 offset:24576
    v_mfma_f32_16x16x32_bf16 v[24:27], v[128:131], v[136:139], v[24:27]
    s_waitcnt lgkmcnt(3)
    ds_read_b64_tr_b16 v[150:151], v40 offset:25088
    v_mfma_f32_16x16x32_bf16 v[4:7], v[140:143], v[108:111], v[4:7]
    s_waitcnt lgkmcnt(2)
    ds_read_b128 v[152:155], v32 offset:17408
    v_mfma_f32_16x16x32_bf16 v[4:7], v[144:147], v[112:115], v[4:7]
    ds_read_b128 v[156:159], v34 offset:17408
    v_mfma_f32_16x16x32_bf16 v[12:15], v[140:143], v[112:115], v[12:15]
    ds_read_b128 v[160:163], v32 offset:17664
    v_mfma_f32_16x16x32_bf16 v[12:15], v[144:147], v[116:119], v[12:15]
    ds_read_b128 v[164:167], v34 offset:17664
    v_mfma_f32_16x16x32_bf16 v[20:23], v[140:143], v[116:119], v[20:23]
    ds_read_b64_tr_b16 v[168:169], v41 offset:24576
    v_mfma_f32_16x16x32_bf16 v[20:23], v[144:147], v[132:135], v[20:23]
    ds_read_b64_tr_b16 v[170:171], v41 offset:25088
    v_mfma_f32_16x16x32_bf16 v[28:31], v[140:143], v[132:135], v[28:31]
    ds_read_b64_tr_b16 v[172:173], v40 offset:28672
    v_mfma_f32_16x16x32_bf16 v[28:31], v[144:147], v[136:139], v[28:31]
    s_waitcnt lgkmcnt(6)
    ds_read_b64_tr_b16 v[174:175], v40 offset:29184
    v_mfma_f32_16x16x32_bf16 v[0:3], v[148:151], v[152:155], v[0:3]
    s_waitcnt lgkmcnt(6)
    ds_read_b64_tr_b16 v[176:177], v40 offset:32768
    v_mfma_f32_16x16x32_bf16 v[8:11], v[148:151], v[156:159], v[8:11]
    s_waitcnt lgkmcnt(6)
    ds_read_b64_tr_b16 v[178:179], v40 offset:33280
    v_mfma_f32_16x16x32_bf16 v[16:19], v[148:151], v[160:163], v[16:19]
    s_waitcnt lgkmcnt(6)
    ds_read_b128 v[180:183], v36 offset:17408
    v_mfma_f32_16x16x32_bf16 v[24:27], v[148:151], v[164:167], v[24:27]
    s_waitcnt lgkmcnt(5)
    ds_read_b128 v[184:187], v38 offset:17408
    v_mfma_f32_16x16x32_bf16 v[4:7], v[168:171], v[152:155], v[4:7]
    ds_read_b64_tr_b16 v[188:189], v41 offset:28672
    v_mfma_f32_16x16x32_bf16 v[12:15], v[168:171], v[156:159], v[12:15]
    ds_read_b64_tr_b16 v[190:191], v41 offset:29184
    v_mfma_f32_16x16x32_bf16 v[20:23], v[168:171], v[160:163], v[20:23]
    ds_read_b64_tr_b16 v[192:193], v41 offset:32768
    v_mfma_f32_16x16x32_bf16 v[28:31], v[168:171], v[164:167], v[28:31]
    s_waitcnt lgkmcnt(7)
    ds_read_b64_tr_b16 v[194:195], v41 offset:33280
    v_mfma_f32_16x16x32_bf16 v[0:3], v[172:175], v[156:159], v[0:3]
    s_waitcnt lgkmcnt(6)
    v_mfma_f32_16x16x32_bf16 v[0:3], v[176:179], v[160:163], v[0:3]
    v_mfma_f32_16x16x32_bf16 v[8:11], v[172:175], v[160:163], v[8:11]
    v_mfma_f32_16x16x32_bf16 v[8:11], v[176:179], v[164:167], v[8:11]
    v_mfma_f32_16x16x32_bf16 v[16:19], v[172:175], v[164:167], v[16:19]
    s_waitcnt lgkmcnt(5)
    v_mfma_f32_16x16x32_bf16 v[16:19], v[176:179], v[180:183], v[16:19]
    s_barrier
    v_mfma_f32_16x16x32_bf16 v[24:27], v[172:175], v[180:183], v[24:27]
    s_waitcnt lgkmcnt(3)
    ds_read_b64_tr_b16 v[196:197], v40 offset:36864
    v_mfma_f32_16x16x32_bf16 v[24:27], v[176:179], v[184:187], v[24:27]
    s_waitcnt lgkmcnt(3)
    ds_read_b64_tr_b16 v[198:199], v40 offset:37376
    v_mfma_f32_16x16x32_bf16 v[4:7], v[188:191], v[156:159], v[4:7]
    s_waitcnt lgkmcnt(2)
    ds_read_b128 v[200:203], v33 offset:17408
    v_mfma_f32_16x16x32_bf16 v[4:7], v[192:195], v[160:163], v[4:7]
    ds_read_b128 v[204:207], v35 offset:17408
    v_mfma_f32_16x16x32_bf16 v[12:15], v[188:191], v[160:163], v[12:15]
    ds_read_b128 v[208:211], v33 offset:17664
    v_mfma_f32_16x16x32_bf16 v[12:15], v[192:195], v[164:167], v[12:15]
    ds_read_b128 v[212:215], v35 offset:17664
    v_mfma_f32_16x16x32_bf16 v[20:23], v[188:191], v[164:167], v[20:23]
    ds_read_b64_tr_b16 v[216:217], v41 offset:36864
    v_mfma_f32_16x16x32_bf16 v[20:23], v[192:195], v[180:183], v[20:23]
    ds_read_b64_tr_b16 v[218:219], v41 offset:37376
    v_mfma_f32_16x16x32_bf16 v[28:31], v[188:191], v[180:183], v[28:31]
    ds_read_b64_tr_b16 v[240:241], v40 offset:40960
    v_mfma_f32_16x16x32_bf16 v[28:31], v[192:195], v[184:187], v[28:31]
    s_waitcnt lgkmcnt(6)
    ds_read_b64_tr_b16 v[242:243], v40 offset:41472
    v_mfma_f32_16x16x32_bf16 v[0:3], v[196:199], v[200:203], v[0:3]
    s_waitcnt lgkmcnt(6)
    ds_read_b64_tr_b16 v[244:245], v40 offset:45056
    v_mfma_f32_16x16x32_bf16 v[8:11], v[196:199], v[204:207], v[8:11]
    s_waitcnt lgkmcnt(6)
    ds_read_b64_tr_b16 v[246:247], v40 offset:45568
    v_mfma_f32_16x16x32_bf16 v[16:19], v[196:199], v[208:211], v[16:19]
    s_waitcnt lgkmcnt(6)
    ds_read_b128 v[52:55], v37 offset:17408
    v_mfma_f32_16x16x32_bf16 v[24:27], v[196:199], v[212:215], v[24:27]
    s_waitcnt lgkmcnt(5)
    ds_read_b128 v[56:59], v39 offset:17408
    v_mfma_f32_16x16x32_bf16 v[4:7], v[216:219], v[200:203], v[4:7]
    ds_read_b64_tr_b16 v[72:73], v41 offset:40960
    v_mfma_f32_16x16x32_bf16 v[12:15], v[216:219], v[204:207], v[12:15]
    ds_read_b64_tr_b16 v[74:75], v41 offset:41472
    v_mfma_f32_16x16x32_bf16 v[20:23], v[216:219], v[208:211], v[20:23]
    ds_read_b64_tr_b16 v[76:77], v41 offset:45056
    v_mfma_f32_16x16x32_bf16 v[28:31], v[216:219], v[212:215], v[28:31]
    s_waitcnt lgkmcnt(7)
    ds_read_b64_tr_b16 v[78:79], v41 offset:45568
    v_mfma_f32_16x16x32_bf16 v[0:3], v[240:243], v[204:207], v[0:3]
    s_waitcnt lgkmcnt(6)
    ds_read_u16 v220, v49 offset:1024
    v_mfma_f32_16x16x32_bf16 v[0:3], v[244:247], v[208:211], v[0:3]
    ds_read_u16 v221, v49 offset:2048
    v_mfma_f32_16x16x32_bf16 v[8:11], v[240:243], v[208:211], v[8:11]
    ds_read_u16 v222, v49 offset:0
    v_mfma_f32_16x16x32_bf16 v[8:11], v[244:247], v[212:215], v[8:11]
    ds_read_u16 v223, v49 offset:3072
    v_mfma_f32_16x16x32_bf16 v[16:19], v[240:243], v[212:215], v[16:19]
    s_waitcnt lgkmcnt(9)
    v_mfma_f32_16x16x32_bf16 v[16:19], v[244:247], v[52:55], v[16:19]
    s_barrier
    v_mfma_f32_16x16x32_bf16 v[24:27], v[240:243], v[52:55], v[24:27]
    s_waitcnt lgkmcnt(7)
    ds_read_b64_tr_b16 v[80:81], v42 offset:0
    v_mfma_f32_16x16x32_bf16 v[24:27], v[244:247], v[56:59], v[24:27]
    s_waitcnt lgkmcnt(7)
    ds_read_b64_tr_b16 v[82:83], v42 offset:512
    v_mfma_f32_16x16x32_bf16 v[4:7], v[72:75], v[204:207], v[4:7]
    s_waitcnt lgkmcnt(6)
    ds_read_b128 v[60:63], v32 offset:34816
    v_mfma_f32_16x16x32_bf16 v[4:7], v[76:79], v[208:211], v[4:7]
    ds_read_b128 v[64:67], v34 offset:34816
    v_mfma_f32_16x16x32_bf16 v[12:15], v[72:75], v[208:211], v[12:15]
    ds_read_b128 v[68:71], v32 offset:35072
    v_mfma_f32_16x16x32_bf16 v[12:15], v[76:79], v[212:215], v[12:15]
    ds_read_b128 v[92:95], v34 offset:35072
    v_mfma_f32_16x16x32_bf16 v[20:23], v[72:75], v[212:215], v[20:23]
    ds_read_b64_tr_b16 v[84:85], v43 offset:0
    v_mfma_f32_16x16x32_bf16 v[20:23], v[76:79], v[52:55], v[20:23]
    s_waitcnt lgkmcnt(7)
    ds_read_b64_tr_b16 v[86:87], v43 offset:512
    v_mfma_f32_16x16x32_bf16 v[28:31], v[72:75], v[52:55], v[28:31]
    ds_read_b64_tr_b16 v[96:97], v42 offset:4096
    v_lshlrev_b32 v220, 16, v220
    v_mfma_f32_16x16x32_bf16 v[28:31], v[76:79], v[56:59], v[28:31]
    s_waitcnt lgkmcnt(6)
    ds_read_b64_tr_b16 v[98:99], v42 offset:4608
    v_mfma_f32_16x16x32_bf16 v[0:3], v[80:83], v[60:63], v[0:3]
    s_waitcnt lgkmcnt(6)
    ds_read_b64_tr_b16 v[88:89], v42 offset:8192
    v_mfma_f32_16x16x32_bf16 v[8:11], v[80:83], v[64:67], v[8:11]
    s_waitcnt lgkmcnt(6)
    ds_read_b64_tr_b16 v[90:91], v42 offset:8704
    v_mfma_f32_16x16x32_bf16 v[16:19], v[80:83], v[68:71], v[16:19]
    s_waitcnt lgkmcnt(6)
    ds_read_b128 v[100:103], v36 offset:34816
    v_mfma_f32_16x16x32_bf16 v[24:27], v[80:83], v[92:95], v[24:27]
    s_waitcnt lgkmcnt(5)
    ds_read_b128 v[104:107], v38 offset:34816
    v_mfma_f32_16x16x32_bf16 v[4:7], v[84:87], v[60:63], v[4:7]
    ds_read_b64_tr_b16 v[120:121], v43 offset:4096
    v_lshlrev_b32 v221, 16, v221
    v_mfma_f32_16x16x32_bf16 v[12:15], v[84:87], v[64:67], v[12:15]
    ds_read_b64_tr_b16 v[122:123], v43 offset:4608
    v_lshlrev_b32 v222, 16, v222
    v_mfma_f32_16x16x32_bf16 v[20:23], v[84:87], v[68:71], v[20:23]
    ds_read_b64_tr_b16 v[124:125], v43 offset:8192
    v_lshlrev_b32 v223, 16, v223
    v_mfma_f32_16x16x32_bf16 v[28:31], v[84:87], v[92:95], v[28:31]
    s_waitcnt lgkmcnt(7)
    ds_read_b64_tr_b16 v[126:127], v43 offset:8704
    v_mfma_f32_16x16x32_bf16 v[0:3], v[96:99], v[64:67], v[0:3]
    s_waitcnt lgkmcnt(6)
    v_add_f32 v220, 0x3727c5ac, v220
    v_cvt_pk_bf16_f32 v220, v220, v220
    v_mfma_f32_16x16x32_bf16 v[0:3], v[88:91], v[68:71], v[0:3]
    v_lshlrev_b32 v220, 16, v220
    v_mfma_f32_16x16x32_bf16 v[8:11], v[96:99], v[68:71], v[8:11]
    v_sqrt_f32 v220, v220
    v_mfma_f32_16x16x32_bf16 v[8:11], v[88:91], v[92:95], v[8:11]
    v_cvt_pk_bf16_f32 v220, v220, v220
    v_lshlrev_b32 v220, 16, v220
    v_mfma_f32_16x16x32_bf16 v[16:19], v[96:99], v[92:95], v[16:19]
    s_waitcnt lgkmcnt(5)
    v_rcp_f32 v220, v220
    v_mfma_f32_16x16x32_bf16 v[16:19], v[88:91], v[100:103], v[16:19]
    s_barrier
    v_cvt_pk_bf16_f32 v220, v220, v220
    v_mfma_f32_16x16x32_bf16 v[24:27], v[96:99], v[100:103], v[24:27]
    s_waitcnt lgkmcnt(3)
    ds_read_b64_tr_b16 v[128:129], v42 offset:12288
    v_mfma_f32_16x16x32_bf16 v[24:27], v[88:91], v[104:107], v[24:27]
    s_waitcnt lgkmcnt(3)
    ds_read_b64_tr_b16 v[130:131], v42 offset:12800
    v_mfma_f32_16x16x32_bf16 v[4:7], v[120:123], v[64:67], v[4:7]
    s_waitcnt lgkmcnt(2)
    ds_read_b128 v[108:111], v33 offset:34816
    v_mfma_f32_16x16x32_bf16 v[4:7], v[124:127], v[68:71], v[4:7]
    ds_read_b128 v[112:115], v35 offset:34816
    v_lshlrev_b32 v220, 16, v220
    v_mfma_f32_16x16x32_bf16 v[12:15], v[120:123], v[68:71], v[12:15]
    ds_read_b128 v[116:119], v33 offset:35072
    v_mul_f32 v220, v220, v221
    v_mfma_f32_16x16x32_bf16 v[12:15], v[124:127], v[92:95], v[12:15]
    ds_read_b128 v[140:143], v35 offset:35072
    v_cvt_pk_bf16_f32 v220, v220, v220
    v_mfma_f32_16x16x32_bf16 v[20:23], v[120:123], v[92:95], v[20:23]
    ds_read_b64_tr_b16 v[132:133], v43 offset:12288
    v_lshlrev_b32 v220, 16, v220
    v_mfma_f32_16x16x32_bf16 v[20:23], v[124:127], v[100:103], v[20:23]
    ds_read_b64_tr_b16 v[134:135], v43 offset:12800
    v_fma_f32 v222, -v222, v220, v223
    v_mfma_f32_16x16x32_bf16 v[28:31], v[120:123], v[100:103], v[28:31]
    ds_read_b64_tr_b16 v[144:145], v42 offset:16384
    v_mul_f32 v220, s32, v220
    v_mfma_f32_16x16x32_bf16 v[28:31], v[124:127], v[104:107], v[28:31]
    s_waitcnt lgkmcnt(6)
    ds_read_b64_tr_b16 v[146:147], v42 offset:16896
    v_mfma_f32_16x16x32_bf16 v[0:3], v[128:131], v[108:111], v[0:3]
    s_waitcnt lgkmcnt(6)
    ds_read_b64_tr_b16 v[136:137], v42 offset:20480
    v_mfma_f32_16x16x32_bf16 v[8:11], v[128:131], v[112:115], v[8:11]
    s_waitcnt lgkmcnt(6)
    ds_read_b64_tr_b16 v[138:139], v42 offset:20992
    v_mfma_f32_16x16x32_bf16 v[16:19], v[128:131], v[116:119], v[16:19]
    s_waitcnt lgkmcnt(6)
    ds_read_b128 v[148:151], v37 offset:34816
    v_mfma_f32_16x16x32_bf16 v[24:27], v[128:131], v[140:143], v[24:27]
    s_waitcnt lgkmcnt(5)
    ds_read_b128 v[152:155], v39 offset:34816
    v_mfma_f32_16x16x32_bf16 v[4:7], v[132:135], v[108:111], v[4:7]
    ds_read_b64_tr_b16 v[168:169], v43 offset:16384
    v_mul_f32 v222, s32, v222
    v_mfma_f32_16x16x32_bf16 v[12:15], v[132:135], v[112:115], v[12:15]
    ds_read_b64_tr_b16 v[170:171], v43 offset:16896
    v_mfma_f32_16x16x32_bf16 v[20:23], v[132:135], v[116:119], v[20:23]
    ds_read_b64_tr_b16 v[172:173], v43 offset:20480
    v_mfma_f32_16x16x32_bf16 v[28:31], v[132:135], v[140:143], v[28:31]
    s_waitcnt lgkmcnt(7)
    ds_read_b64_tr_b16 v[174:175], v43 offset:20992
    v_mfma_f32_16x16x32_bf16 v[0:3], v[144:147], v[112:115], v[0:3]
    s_waitcnt lgkmcnt(6)
    s_nop 1
    v_mfma_f32_16x16x32_bf16 v[0:3], v[136:139], v[116:119], v[0:3]
    v_mov_b32_dpp v224, v220 row_newbcast:0 row_mask:0xf bank_mask:0xf
    v_mov_b32_dpp v225, v220 row_newbcast:1 row_mask:0xf bank_mask:0xf
    v_mfma_f32_16x16x32_bf16 v[8:11], v[144:147], v[116:119], v[8:11]
    v_mov_b32_dpp v226, v220 row_newbcast:2 row_mask:0xf bank_mask:0xf
    v_mov_b32_dpp v227, v220 row_newbcast:3 row_mask:0xf bank_mask:0xf
    v_mfma_f32_16x16x32_bf16 v[8:11], v[136:139], v[140:143], v[8:11]
    v_mov_b32_dpp v228, v222 row_newbcast:0 row_mask:0xf bank_mask:0xf
    v_mov_b32_dpp v229, v222 row_newbcast:1 row_mask:0xf bank_mask:0xf
    v_mfma_f32_16x16x32_bf16 v[16:19], v[144:147], v[140:143], v[16:19]
    s_waitcnt lgkmcnt(5)
    v_mov_b32_dpp v230, v222 row_newbcast:2 row_mask:0xf bank_mask:0xf
    v_mov_b32_dpp v231, v222 row_newbcast:3 row_mask:0xf bank_mask:0xf
    v_mfma_f32_16x16x32_bf16 v[16:19], v[136:139], v[148:151], v[16:19]
    s_barrier
    v_mov_b32_dpp v232, v220 row_newbcast:4 row_mask:0xf bank_mask:0xf
    v_mfma_f32_16x16x32_bf16 v[24:27], v[144:147], v[148:151], v[24:27]
    s_waitcnt lgkmcnt(3)
    ds_read_b64_tr_b16 v[176:177], v42 offset:24576
    v_mfma_f32_16x16x32_bf16 v[24:27], v[136:139], v[152:155], v[24:27]
    s_waitcnt lgkmcnt(3)
    ds_read_b64_tr_b16 v[178:179], v42 offset:25088
    v_mfma_f32_16x16x32_bf16 v[4:7], v[168:171], v[112:115], v[4:7]
    s_waitcnt lgkmcnt(2)
    ds_read_b128 v[156:159], v32 offset:52224
    v_mfma_f32_16x16x32_bf16 v[4:7], v[172:175], v[116:119], v[4:7]
    ds_read_b128 v[160:163], v34 offset:52224
    v_mov_b32_dpp v233, v220 row_newbcast:5 row_mask:0xf bank_mask:0xf
    v_mfma_f32_16x16x32_bf16 v[12:15], v[168:171], v[116:119], v[12:15]
    ds_read_b128 v[164:167], v32 offset:52480
    v_mov_b32_dpp v234, v220 row_newbcast:6 row_mask:0xf bank_mask:0xf
    v_mfma_f32_16x16x32_bf16 v[12:15], v[172:175], v[140:143], v[12:15]
    ds_read_b128 v[188:191], v34 offset:52480
    v_mov_b32_dpp v235, v220 row_newbcast:7 row_mask:0xf bank_mask:0xf
    v_mfma_f32_16x16x32_bf16 v[20:23], v[168:171], v[140:143], v[20:23]
    ds_read_b64_tr_b16 v[180:181], v43 offset:24576
    v_mov_b32_dpp v236, v222 row_newbcast:4 row_mask:0xf bank_mask:0xf
    v_mfma_f32_16x16x32_bf16 v[20:23], v[172:175], v[148:151], v[20:23]
    ds_read_b64_tr_b16 v[182:183], v43 offset:25088
    v_mov_b32_dpp v237, v222 row_newbcast:5 row_mask:0xf bank_mask:0xf
    v_mfma_f32_16x16x32_bf16 v[28:31], v[168:171], v[148:151], v[28:31]
    ds_read_b64_tr_b16 v[192:193], v42 offset:28672
    v_mov_b32_dpp v238, v222 row_newbcast:6 row_mask:0xf bank_mask:0xf
    v_mfma_f32_16x16x32_bf16 v[28:31], v[172:175], v[152:155], v[28:31]
    s_waitcnt lgkmcnt(6)
    ds_read_b64_tr_b16 v[194:195], v42 offset:29184
    v_mfma_f32_16x16x32_bf16 v[0:3], v[176:179], v[156:159], v[0:3]
    s_waitcnt lgkmcnt(6)
    ds_read_b64_tr_b16 v[184:185], v42 offset:32768
    v_mfma_f32_16x16x32_bf16 v[8:11], v[176:179], v[160:163], v[8:11]
    s_waitcnt lgkmcnt(6)
    ds_read_b64_tr_b16 v[186:187], v42 offset:33280
    v_mfma_f32_16x16x32_bf16 v[16:19], v[176:179], v[164:167], v[16:19]
    s_waitcnt lgkmcnt(6)
    ds_read_b128 v[196:199], v36 offset:52224
    v_mfma_f32_16x16x32_bf16 v[24:27], v[176:179], v[188:191], v[24:27]
    s_waitcnt lgkmcnt(5)
    ds_read_b128 v[200:203], v38 offset:52224
    v_mfma_f32_16x16x32_bf16 v[4:7], v[180:183], v[156:159], v[4:7]
    ds_read_b64_tr_b16 v[216:217], v43 offset:28672
    v_mov_b32_dpp v239, v222 row_newbcast:7 row_mask:0xf bank_mask:0xf
    v_mfma_f32_16x16x32_bf16 v[12:15], v[180:183], v[160:163], v[12:15]
    ds_read_b64_tr_b16 v[218:219], v43 offset:29184
    v_mfma_f32_16x16x32_bf16 v[20:23], v[180:183], v[164:167], v[20:23]
    ds_read_b64_tr_b16 v[240:241], v43 offset:32768
    v_mfma_f32_16x16x32_bf16 v[28:31], v[180:183], v[188:191], v[28:31]
    s_waitcnt lgkmcnt(7)
    ds_read_b64_tr_b16 v[242:243], v43 offset:33280
    v_mfma_f32_16x16x32_bf16 v[0:3], v[192:195], v[160:163], v[0:3]
    s_waitcnt lgkmcnt(6)
    v_mfma_f32_16x16x32_bf16 v[0:3], v[184:187], v[164:167], v[0:3]
    v_mfma_f32_16x16x32_bf16 v[8:11], v[192:195], v[164:167], v[8:11]
    v_mfma_f32_16x16x32_bf16 v[8:11], v[184:187], v[188:191], v[8:11]
    v_mfma_f32_16x16x32_bf16 v[16:19], v[192:195], v[188:191], v[16:19]
    s_waitcnt lgkmcnt(5)
    v_mfma_f32_16x16x32_bf16 v[16:19], v[184:187], v[196:199], v[16:19]
    s_barrier
    v_mfma_f32_16x16x32_bf16 v[24:27], v[192:195], v[196:199], v[24:27]
    s_waitcnt lgkmcnt(3)
    ds_read_b64_tr_b16 v[244:245], v40 offset:0
    v_mfma_f32_16x16x32_bf16 v[24:27], v[184:187], v[200:203], v[24:27]
    s_waitcnt lgkmcnt(3)
    ds_read_b64_tr_b16 v[246:247], v40 offset:512
    v_mfma_f32_16x16x32_bf16 v[4:7], v[216:219], v[160:163], v[4:7]
    s_waitcnt lgkmcnt(2)
    ds_read_b128 v[204:207], v33 offset:52224
    v_mfma_f32_16x16x32_bf16 v[4:7], v[240:243], v[164:167], v[4:7]
    ds_read_b128 v[208:211], v35 offset:52224
    v_mfma_f32_16x16x32_bf16 v[12:15], v[216:219], v[164:167], v[12:15]
    ds_read_b128 v[212:215], v33 offset:52480
    v_mfma_f32_16x16x32_bf16 v[12:15], v[240:243], v[188:191], v[12:15]
    ds_read_b128 v[72:75], v35 offset:52480
    v_mfma_f32_16x16x32_bf16 v[20:23], v[216:219], v[188:191], v[20:23]
    ds_read_b64_tr_b16 v[52:53], v41 offset:0
    v_mfma_f32_16x16x32_bf16 v[20:23], v[240:243], v[196:199], v[20:23]
    ds_read_b64_tr_b16 v[54:55], v41 offset:512
    v_mfma_f32_16x16x32_bf16 v[28:31], v[216:219], v[196:199], v[28:31]
    ds_read_b64_tr_b16 v[76:77], v40 offset:4096
    v_mfma_f32_16x16x32_bf16 v[28:31], v[240:243], v[200:203], v[28:31]
    s_waitcnt lgkmcnt(6)
    ds_read_b64_tr_b16 v[78:79], v40 offset:4608
    v_mfma_f32_16x16x32_bf16 v[0:3], v[244:247], v[204:207], v[0:3]
    s_waitcnt lgkmcnt(6)
    ds_read_b64_tr_b16 v[56:57], v40 offset:8192
    v_mfma_f32_16x16x32_bf16 v[8:11], v[244:247], v[208:211], v[8:11]
    s_waitcnt lgkmcnt(6)
    ds_read_b64_tr_b16 v[58:59], v40 offset:8704
    v_mfma_f32_16x16x32_bf16 v[16:19], v[244:247], v[212:215], v[16:19]
    s_waitcnt lgkmcnt(6)
    ds_read_b128 v[80:83], v37 offset:52224
    v_mfma_f32_16x16x32_bf16 v[24:27], v[244:247], v[72:75], v[24:27]
    s_waitcnt lgkmcnt(5)
    ds_read_b128 v[60:63], v39 offset:52224
    v_mfma_f32_16x16x32_bf16 v[4:7], v[52:55], v[204:207], v[4:7]
    ds_read_b64_tr_b16 v[84:85], v41 offset:4096
    v_mfma_f32_16x16x32_bf16 v[12:15], v[52:55], v[208:211], v[12:15]
    ds_read_b64_tr_b16 v[86:87], v41 offset:4608
    v_mfma_f32_16x16x32_bf16 v[20:23], v[52:55], v[212:215], v[20:23]
    ds_read_b64_tr_b16 v[96:97], v41 offset:8192
    v_mfma_f32_16x16x32_bf16 v[28:31], v[52:55], v[72:75], v[28:31]
    s_waitcnt lgkmcnt(7)
    ds_read_b64_tr_b16 v[98:99], v41 offset:8704
    v_mfma_f32_16x16x32_bf16 v[0:3], v[76:79], v[208:211], v[0:3]
    s_waitcnt lgkmcnt(6)
    v_mfma_f32_16x16x32_bf16 v[0:3], v[56:59], v[212:215], v[0:3]
    v_mfma_f32_16x16x32_bf16 v[8:11], v[76:79], v[212:215], v[8:11]
    v_mfma_f32_16x16x32_bf16 v[8:11], v[56:59], v[72:75], v[8:11]
    s_barrier
    v_mfma_f32_16x16x32_bf16 v[16:19], v[76:79], v[72:75], v[16:19]
    s_waitcnt lgkmcnt(5)
    ds_read_b64_tr_b16 v[88:89], v40 offset:12288
    v_mfma_f32_16x16x32_bf16 v[16:19], v[56:59], v[80:83], v[16:19]
    ds_read_b64_tr_b16 v[90:91], v40 offset:12800
    v_mfma_f32_16x16x32_bf16 v[24:27], v[76:79], v[80:83], v[24:27]
    s_waitcnt lgkmcnt(5)
    ds_read_b128 v[64:67], v32 offset:0
    v_mfma_f32_16x16x32_bf16 v[24:27], v[56:59], v[60:63], v[24:27]
    s_waitcnt lgkmcnt(5)
    ds_read_b128 v[68:71], v34 offset:0
    v_mfma_f32_16x16x32_bf16 v[4:7], v[84:87], v[208:211], v[4:7]
    s_waitcnt lgkmcnt(4)
    ds_read_b128 v[92:95], v32 offset:256
    v_mfma_f32_16x16x32_bf16 v[4:7], v[96:99], v[212:215], v[4:7]
    ds_read_b128 v[120:123], v34 offset:256
    v_mfma_f32_16x16x32_bf16 v[12:15], v[84:87], v[212:215], v[12:15]
    ds_read_b64_tr_b16 v[100:101], v41 offset:12288
    v_mfma_f32_16x16x32_bf16 v[12:15], v[96:99], v[72:75], v[12:15]
    ds_read_b64_tr_b16 v[102:103], v41 offset:12800
    v_mfma_f32_16x16x32_bf16 v[20:23], v[84:87], v[72:75], v[20:23]
    ds_read_b64_tr_b16 v[124:125], v40 offset:16384
    v_mfma_f32_16x16x32_bf16 v[20:23], v[96:99], v[80:83], v[20:23]
    ds_read_b64_tr_b16 v[126:127], v40 offset:16896
    v_mfma_f32_16x16x32_bf16 v[28:31], v[84:87], v[80:83], v[28:31]
    ds_read_b64_tr_b16 v[104:105], v40 offset:20480
    v_mfma_f32_16x16x32_bf16 v[28:31], v[96:99], v[60:63], v[28:31]
    s_waitcnt lgkmcnt(8)
    ds_read_b64_tr_b16 v[106:107], v40 offset:20992
    v_mfma_f32_16x16x32_bf16 v[0:3], v[88:91], v[64:67], v[0:3]
    s_waitcnt lgkmcnt(8)
    ds_read_b128 v[128:131], v36 offset:0
    v_mfma_f32_16x16x32_bf16 v[8:11], v[88:91], v[68:71], v[8:11]
    s_waitcnt lgkmcnt(8)
    ds_read_b128 v[108:111], v38 offset:0
    v_mfma_f32_16x16x32_bf16 v[16:19], v[88:91], v[92:95], v[16:19]
    s_waitcnt lgkmcnt(8)
    ds_read_b64_tr_b16 v[132:133], v41 offset:16384
    v_mfma_f32_16x16x32_bf16 v[24:27], v[88:91], v[120:123], v[24:27]
    s_waitcnt lgkmcnt(7)
    ds_read_b64_tr_b16 v[134:135], v41 offset:16896
    v_mfma_f32_16x16x32_bf16 v[4:7], v[100:103], v[64:67], v[4:7]
    ds_read_b64_tr_b16 v[144:145], v41 offset:20480
    v_mfma_f32_16x16x32_bf16 v[12:15], v[100:103], v[68:71], v[12:15]
    ds_read_b64_tr_b16 v[146:147], v41 offset:20992
    v_mfma_f32_16x16x32_bf16 v[20:23], v[100:103], v[92:95], v[20:23]
    v_mfma_f32_16x16x32_bf16 v[28:31], v[100:103], v[120:123], v[28:31]
    s_waitcnt lgkmcnt(8)
    v_mfma_f32_16x16x32_bf16 v[0:3], v[124:127], v[68:71], v[0:3]
    s_waitcnt lgkmcnt(6)
    v_mfma_f32_16x16x32_bf16 v[0:3], v[104:107], v[92:95], v[0:3]
    s_barrier
    v_mfma_f32_16x16x32_bf16 v[8:11], v[124:127], v[92:95], v[8:11]
    ds_read_b64_tr_b16 v[136:137], v40 offset:24576
    v_mfma_f32_16x16x32_bf16 v[8:11], v[104:107], v[120:123], v[8:11]
    ds_read_b64_tr_b16 v[138:139], v40 offset:25088
    v_mfma_f32_16x16x32_bf16 v[16:19], v[124:127], v[120:123], v[16:19]
    s_waitcnt lgkmcnt(5)
    ds_read_b128 v[112:115], v33 offset:0
    v_mfma_f32_16x16x32_bf16 v[16:19], v[104:107], v[128:131], v[16:19]
L_pg0:
    s_cbranch_scc1 L_consumer
    ds_read_b64_tr_b16 v[116:117], v40 offset:28672
    v_mfma_f32_16x16x32_bf16 v[24:27], v[124:127], v[128:131], v[24:27]
    ds_read_b64_tr_b16 v[118:119], v40 offset:29184
    v_mfma_f32_16x16x32_bf16 v[24:27], v[104:107], v[108:111], v[24:27]
    s_waitcnt lgkmcnt(5)
    ds_read_b128 v[140:143], v35 offset:0
    v_mfma_f32_16x16x32_bf16 v[4:7], v[132:135], v[68:71], v[4:7]
    ds_read_b64_tr_b16 v[168:169], v40 offset:32768
    v_mfma_f32_16x16x32_bf16 v[4:7], v[144:147], v[92:95], v[4:7]
    ds_read_b64_tr_b16 v[170:171], v40 offset:33280
    v_mfma_f32_16x16x32_bf16 v[12:15], v[132:135], v[92:95], v[12:15]
    ds_read_b128 v[148:151], v33 offset:256
    v_mfma_f32_16x16x32_bf16 v[12:15], v[144:147], v[120:123], v[12:15]
    ds_read_b128 v[172:175], v35 offset:256
    v_mfma_f32_16x16x32_bf16 v[20:23], v[132:135], v[120:123], v[20:23]
    ds_read_b128 v[152:155], v37 offset:0
    v_mfma_f32_16x16x32_bf16 v[20:23], v[144:147], v[128:131], v[20:23]
    ds_read_b128 v[176:179], v39 offset:0
    v_mfma_f32_16x16x32_bf16 v[28:31], v[132:135], v[128:131], v[28:31]
    ds_read_b64_tr_b16 v[156:157], v41 offset:24576
    v_mfma_f32_16x16x32_bf16 v[28:31], v[144:147], v[108:111], v[28:31]
    s_waitcnt lgkmcnt(9)
    ds_read_b64_tr_b16 v[158:159], v41 offset:25088
    v_mfma_f32_16x16x32_bf16 v[0:3], v[136:139], v[112:115], v[0:3]
    s_waitcnt lgkmcnt(8)
    ds_read_b64_tr_b16 v[220:221], v41 offset:28672
    v_mfma_f32_16x16x32_bf16 v[0:3], v[116:119], v[140:143], v[0:3]
    s_waitcnt lgkmcnt(6)
    ds_read_b64_tr_b16 v[222:223], v41 offset:29184
    v_mfma_f32_16x16x32_bf16 v[0:3], v[168:171], v[148:151], v[0:3]
    ds_read_b64_tr_b16 v[180:181], v41 offset:32768
    v_mfma_f32_16x16x32_bf16 v[8:11], v[136:139], v[140:143], v[8:11]
    ds_read_b64_tr_b16 v[182:183], v41 offset:33280
    v_mfma_f32_16x16x32_bf16 v[8:11], v[116:119], v[148:151], v[8:11]
    s_waitcnt lgkmcnt(8)
    v_mfma_f32_16x16x32_bf16 v[8:11], v[168:171], v[172:175], v[8:11]
    v_mfma_f32_16x16x32_bf16 v[16:19], v[136:139], v[148:151], v[16:19]
    v_mfma_f32_16x16x32_bf16 v[16:19], v[116:119], v[172:175], v[16:19]
    s_waitcnt lgkmcnt(6)
    s_barrier
    v_mfma_f32_16x16x32_bf16 v[16:19], v[168:171], v[152:155], v[16:19]
    ds_read_b64_tr_b16 v[192:193], v40 offset:36864
    v_mfma_f32_16x16x32_bf16 v[24:27], v[136:139], v[172:175], v[24:27]
    ds_read_b64_tr_b16 v[194:195], v40 offset:37376
    v_mfma_f32_16x16x32_bf16 v[24:27], v[116:119], v[152:155], v[24:27]
    ds_read_b128 v[184:187], v32 offset:17408
    v_mfma_f32_16x16x32_bf16 v[24:27], v[168:171], v[176:179], v[24:27]
    s_waitcnt lgkmcnt(5)
    ds_read_b64_tr_b16 v[160:161], v40 offset:40960
    v_mfma_f32_16x16x32_bf16 v[4:7], v[156:159], v[112:115], v[4:7]
    ds_read_b64_tr_b16 v[162:163], v40 offset:41472
    v_mfma_f32_16x16x32_bf16 v[4:7], v[220:223], v[140:143], v[4:7]
    s_waitcnt lgkmcnt(5)
    ds_read_b128 v[164:167], v34 offset:17408
    v_mfma_f32_16x16x32_bf16 v[4:7], v[180:183], v[148:151], v[4:7]
    ds_read_b64_tr_b16 v[188:189], v40 offset:45056
    v_mfma_f32_16x16x32_bf16 v[12:15], v[156:159], v[140:143], v[12:15]
    ds_read_b64_tr_b16 v[190:191], v40 offset:45568
    v_mfma_f32_16x16x32_bf16 v[12:15], v[220:223], v[148:151], v[12:15]
    ds_read_b128 v[216:219], v32 offset:17664
    v_mfma_f32_16x16x32_bf16 v[12:15], v[180:183], v[172:175], v[12:15]
    ds_read_b128 v[196:199], v34 offset:17664
    v_mfma_f32_16x16x32_bf16 v[20:23], v[156:159], v[148:151], v[20:23]
    ds_read_b128 v[240:243], v36 offset:17408
    v_mfma_f32_16x16x32_bf16 v[20:23], v[220:223], v[172:175], v[20:23]
    ds_read_b128 v[200:203], v38 offset:17408
    v_mfma_f32_16x16x32_bf16 v[20:23], v[180:183], v[152:155], v[20:23]
    ds_read_b64_tr_b16 v[244:245], v41 offset:36864
    v_mfma_f32_16x16x32_bf16 v[28:31], v[156:159], v[172:175], v[28:31]
    ds_read_b64_tr_b16 v[246:247], v41 offset:37376
    v_mfma_f32_16x16x32_bf16 v[28:31], v[220:223], v[152:155], v[28:31]
    ds_read_b64_tr_b16 v[204:205], v41 offset:40960
    v_mfma_f32_16x16x32_bf16 v[28:31], v[180:183], v[176:179], v[28:31]
    s_waitcnt lgkmcnt(9)
    ds_read_b64_tr_b16 v[206:207], v41 offset:41472
    v_mfma_f32_16x16x32_bf16 v[0:3], v[192:195], v[184:187], v[0:3]
    ds_read_b64_tr_b16 v[52:53], v41 offset:45056
    v_mfma_f32_16x16x32_bf16 v[0:3], v[160:163], v[164:167], v[0:3]
    s_waitcnt lgkmcnt(8)
    ds_read_b64_tr_b16 v[54:55], v41 offset:45568
    v_mfma_f32_16x16x32_bf16 v[0:3], v[188:191], v[216:219], v[0:3]
    v_mfma_f32_16x16x32_bf16 v[8:11], v[192:195], v[164:167], v[8:11]
    s_barrier
    v_mfma_f32_16x16x32_bf16 v[8:11], v[160:163], v[216:219], v[8:11]
    s_waitcnt lgkmcnt(7)
    ds_read_b64_tr_b16 v[76:77], v42 offset:0
    v_mfma_f32_16x16x32_bf16 v[8:11], v[188:191], v[196:199], v[8:11]
    ds_read_b64_tr_b16 v[78:79], v42 offset:512
    v_mfma_f32_16x16x32_bf16 v[16:19], v[192:195], v[216:219], v[16:19]
    ds_read_b128 v[56:59], v33 offset:17408
    v_mfma_f32_16x16x32_bf16 v[16:19], v[160:163], v[196:199], v[16:19]
    ds_read_b64_tr_b16 v[208:209], v42 offset:4096
    v_mfma_f32_16x16x32_bf16 v[16:19], v[188:191], v[240:243], v[16:19]
    ds_read_b64_tr_b16 v[210:211], v42 offset:4608
    v_mfma_f32_16x16x32_bf16 v[24:27], v[192:195], v[196:199], v[24:27]
    ds_read_b128 v[212:215], v35 offset:17408
    v_mfma_f32_16x16x32_bf16 v[24:27], v[160:163], v[240:243], v[24:27]
    s_waitcnt lgkmcnt(7)
    ds_read_b64_tr_b16 v[72:73], v42 offset:8192
    v_mfma_f32_16x16x32_bf16 v[24:27], v[188:191], v[200:203], v[24:27]
    ds_read_b64_tr_b16 v[74:75], v42 offset:8704
    v_mfma_f32_16x16x32_bf16 v[4:7], v[244:247], v[184:187], v[4:7]
    ds_read_b128 v[84:87], v33 offset:17664
    v_mfma_f32_16x16x32_bf16 v[4:7], v[204:207], v[164:167], v[4:7]
    s_waitcnt lgkmcnt(9)
    ds_read_b128 v[80:83], v35 offset:17664
    v_mfma_f32_16x16x32_bf16 v[4:7], v[52:55], v[216:219], v[4:7]
    ds_read_b128 v[96:99], v37 offset:17408
    v_mfma_f32_16x16x32_bf16 v[12:15], v[244:247], v[164:167], v[12:15]
    ds_read_b128 v[60:63], v39 offset:17408
    v_mfma_f32_16x16x32_bf16 v[12:15], v[204:207], v[216:219], v[12:15]
    ds_read_b64_tr_b16 v[88:89], v43 offset:0
    v_mfma_f32_16x16x32_bf16 v[12:15], v[52:55], v[196:199], v[12:15]
    ds_read_b64_tr_b16 v[90:91], v43 offset:512
    v_mfma_f32_16x16x32_bf16 v[20:23], v[244:247], v[216:219], v[20:23]
    ds_read_b64_tr_b16 v[64:65], v43 offset:4096
    v_mfma_f32_16x16x32_bf16 v[20:23], v[204:207], v[196:199], v[20:23]
    ds_read_b64_tr_b16 v[66:67], v43 offset:4608
    v_mfma_f32_16x16x32_bf16 v[20:23], v[52:55], v[240:243], v[20:23]
    ds_read_b64_tr_b16 v[100:101], v43 offset:8192
    v_mfma_f32_16x16x32_bf16 v[28:31], v[244:247], v[196:199], v[28:31]
    ds_read_b64_tr_b16 v[102:103], v43 offset:8704
    v_mfma_f32_16x16x32_bf16 v[28:31], v[204:207], v[240:243], v[28:31]
    v_mfma_f32_16x16x32_bf16 v[28:31], v[52:55], v[200:203], v[28:31]
    s_waitcnt lgkmcnt(8)
    v_mfma_f32_16x16x32_bf16 v[0:3], v[76:79], v[56:59], v[0:3]
    s_barrier
    v_mfma_f32_16x16x32_bf16 v[0:3], v[208:211], v[212:215], v[0:3]
    ds_read_b64_tr_b16 v[124:125], v42 offset:12288
    v_mfma_f32_16x16x32_bf16 v[0:3], v[72:75], v[84:87], v[0:3]
    ds_read_b64_tr_b16 v[126:127], v42 offset:12800
    v_mfma_f32_16x16x32_bf16 v[8:11], v[76:79], v[212:215], v[8:11]
    ds_read_b128 v[104:107], v32 offset:34816
    v_mfma_f32_16x16x32_bf16 v[8:11], v[208:211], v[84:87], v[8:11]
    ds_read_b64_tr_b16 v[68:69], v42 offset:16384
    v_mfma_f32_16x16x32_bf16 v[8:11], v[72:75], v[80:83], v[8:11]
    ds_read_b64_tr_b16 v[70:71], v42 offset:16896
    v_mfma_f32_16x16x32_bf16 v[16:19], v[76:79], v[84:87], v[16:19]
    ds_read_b128 v[92:95], v34 offset:34816
    v_mfma_f32_16x16x32_bf16 v[16:19], v[208:211], v[80:83], v[16:19]
    s_waitcnt lgkmcnt(6)
    ds_read_b64_tr_b16 v[120:121], v42 offset:20480
    v_mfma_f32_16x16x32_bf16 v[16:19], v[72:75], v[96:99], v[16:19]
    ds_read_b64_tr_b16 v[122:123], v42 offset:20992
    v_mfma_f32_16x16x32_bf16 v[24:27], v[76:79], v[80:83], v[24:27]
    ds_read_b128 v[132:135], v32 offset:35072
    v_mfma_f32_16x16x32_bf16 v[24:27], v[208:211], v[96:99], v[24:27]
    ds_read_b64_tr_b16 v[128:129], v43 offset:12288
    v_mfma_f32_16x16x32_bf16 v[24:27], v[72:75], v[60:63], v[24:27]
    ds_read_b64_tr_b16 v[130:131], v43 offset:12800
    v_mfma_f32_16x16x32_bf16 v[4:7], v[88:91], v[56:59], v[4:7]
    ds_read_b64_tr_b16 v[144:145], v43 offset:16384
    v_mfma_f32_16x16x32_bf16 v[4:7], v[64:67], v[212:215], v[4:7]
    ds_read_b64_tr_b16 v[146:147], v43 offset:16896
    v_mfma_f32_16x16x32_bf16 v[4:7], v[100:103], v[84:87], v[4:7]
    ds_read_b64_tr_b16 v[108:109], v43 offset:20480
    v_mfma_f32_16x16x32_bf16 v[12:15], v[88:91], v[212:215], v[12:15]
    ds_read_b64_tr_b16 v[110:111], v43 offset:20992
    v_mfma_f32_16x16x32_bf16 v[12:15], v[64:67], v[84:87], v[12:15]
    s_barrier
    ds_read_b64_tr_b16 v[136:137], v42 offset:24576
    ds_read_b64_tr_b16 v[138:139], v42 offset:25088
    v_mfma_f32_16x16x32_bf16 v[12:15], v[100:103], v[80:83], v[12:15]
    ds_read_b128 v[116:119], v33 offset:34816
    ds_read_b64_tr_b16 v[168:169], v42 offset:28672
    v_mfma_f32_16x16x32_bf16 v[20:23], v[88:91], v[84:87], v[20:23]
    ds_read_b64_tr_b16 v[170:171], v42 offset:29184
    v_mfma_f32_16x16x32_bf16 v[20:23], v[64:67], v[80:83], v[20:23]
    ds_read_b128 v[112:115], v35 offset:34816
    v_mfma_f32_16x16x32_bf16 v[20:23], v[100:103], v[96:99], v[20:23]
    ds_read_b64_tr_b16 v[140:141], v42 offset:32768
    v_mfma_f32_16x16x32_bf16 v[28:31], v[88:91], v[80:83], v[28:31]
    ds_read_b64_tr_b16 v[142:143], v42 offset:33280
    v_mfma_f32_16x16x32_bf16 v[28:31], v[64:67], v[96:99], v[28:31]
    ds_read_b128 v[148:151], v33 offset:35072
    v_mfma_f32_16x16x32_bf16 v[28:31], v[100:103], v[60:63], v[28:31]
    s_waitcnt lgkmcnt(11)
    ds_read_b64_tr_b16 v[156:157], v43 offset:24576
    v_mfma_f32_16x16x32_bf16 v[0:3], v[124:127], v[104:107], v[0:3]
    ds_read_b64_tr_b16 v[158:159], v43 offset:25088
    v_mfma_f32_16x16x32_bf16 v[0:3], v[68:71], v[92:95], v[0:3]
    ds_read_b64_tr_b16 v[172:173], v43 offset:28672
    v_mfma_f32_16x16x32_bf16 v[0:3], v[120:123], v[132:135], v[0:3]
    s_waitcnt lgkmcnt(9)
    ds_read_b64_tr_b16 v[174:175], v43 offset:29184
    v_mfma_f32_16x16x32_bf16 v[0:3], v[136:139], v[116:119], v[0:3]
    s_waitcnt lgkmcnt(7)
    ds_read_b64_tr_b16 v[220:221], v43 offset:32768
    v_mfma_f32_16x16x32_bf16 v[0:3], v[168:171], v[112:115], v[0:3]
    s_waitcnt lgkmcnt(5)
    ds_read_b64_tr_b16 v[222:223], v43 offset:33280
    v_mfma_f32_16x16x32_bf16 v[0:3], v[140:143], v[148:151], v[0:3]
    ds_read_b128 v[152:155], v34 offset:35072
    s_nop 0
    v_mfma_f32_16x16x32_bf16 v[4:7], v[128:131], v[104:107], v[4:7]
    ds_read_b128 v[180:183], v35 offset:35072
    s_nop 0
    v_mfma_f32_16x16x32_bf16 v[4:7], v[144:147], v[92:95], v[4:7]
    ds_read_b128 v[176:179], v36 offset:34816
    s_nop 0
    v_mfma_f32_16x16x32_bf16 v[4:7], v[108:111], v[132:135], v[4:7]
    s_waitcnt lgkmcnt(7)
    ds_read_b128 v[192:195], v37 offset:34816
    v_mfma_f32_16x16x32_bf16 v[4:7], v[156:159], v[116:119], v[4:7]
    s_waitcnt lgkmcnt(6)
    ds_read_b128 v[160:163], v38 offset:34816
    v_mfma_f32_16x16x32_bf16 v[4:7], v[172:175], v[112:115], v[4:7]
    s_waitcnt lgkmcnt(5)
    ds_read_b128 v[188:191], v39 offset:34816
    v_mfma_f32_16x16x32_bf16 v[4:7], v[220:223], v[148:151], v[4:7]
    v_fma_f32 v184, v0, v224, v228
    v_fma_f32 v185, v1, v225, v229
    v_mfma_f32_16x16x32_bf16 v[8:11], v[124:127], v[92:95], v[8:11]
    v_fma_f32 v186, v2, v226, v230
    v_fma_f32 v187, v3, v227, v231
    v_mfma_f32_16x16x32_bf16 v[8:11], v[68:71], v[132:135], v[8:11]
    s_waitcnt lgkmcnt(5)
    v_exp_f32 v164, -v184
    v_mfma_f32_16x16x32_bf16 v[8:11], v[120:123], v[152:155], v[8:11]
    v_exp_f32 v165, -v185
    v_mfma_f32_16x16x32_bf16 v[8:11], v[136:139], v[112:115], v[8:11]
    v_exp_f32 v166, -v186
    v_mfma_f32_16x16x32_bf16 v[8:11], v[168:171], v[148:151], v[8:11]
    s_waitcnt lgkmcnt(4)
    v_exp_f32 v167, -v187
    v_mfma_f32_16x16x32_bf16 v[8:11], v[140:143], v[180:183], v[8:11]
    v_fma_f32 v164, v164, s32, s32
    v_fma_f32 v165, v165, s32, s32
    v_mfma_f32_16x16x32_bf16 v[12:15], v[128:131], v[92:95], v[12:15]
    v_fma_f32 v166, v166, s32, s32
    v_fma_f32 v167, v167, s32, s32
    v_mfma_f32_16x16x32_bf16 v[12:15], v[144:147], v[132:135], v[12:15]
    v_rcp_f32 v164, v164
    v_mfma_f32_16x16x32_bf16 v[12:15], v[108:111], v[152:155], v[12:15]
    v_rcp_f32 v165, v165
    v_mfma_f32_16x16x32_bf16 v[12:15], v[156:159], v[112:115], v[12:15]
    v_rcp_f32 v166, v166
    v_mfma_f32_16x16x32_bf16 v[12:15], v[172:175], v[148:151], v[12:15]
    v_rcp_f32 v167, v167
    v_mfma_f32_16x16x32_bf16 v[12:15], v[220:223], v[180:183], v[12:15]
    v_mul_f32 v184, v184, v164
    v_mul_f32 v185, v185, v165
    v_mfma_f32_16x16x32_bf16 v[16:19], v[124:127], v[132:135], v[16:19]
    v_mul_f32 v186, v186, v166
    v_mul_f32 v187, v187, v167
    v_mfma_f32_16x16x32_bf16 v[16:19], v[68:71], v[152:155], v[16:19]
    s_waitcnt lgkmcnt(0)
    v_cvt_pk_bf16_f32 v216, v184, v185
    v_cvt_pk_bf16_f32 v217, v186, v187
    v_mfma_f32_16x16x32_bf16 v[16:19], v[120:123], v[176:179], v[16:19]
    ds_write_b64 v45, v[216:217] offset:0
    v_mfma_f32_16x16x32_bf16 v[16:19], v[136:139], v[148:151], v[16:19]
    v_fma_f32 v244, v4, v232, v236
    v_fma_f32 v245, v5, v233, v237
    v_mfma_f32_16x16x32_bf16 v[16:19], v[168:171], v[180:183], v[16:19]
    v_fma_f32 v246, v6, v234, v238
    v_fma_f32 v247, v7, v235, v239
    v_mfma_f32_16x16x32_bf16 v[16:19], v[140:143], v[192:195], v[16:19]
    v_exp_f32 v196, -v244
    v_mfma_f32_16x16x32_bf16 v[20:23], v[128:131], v[132:135], v[20:23]
    v_exp_f32 v197, -v245
    v_mfma_f32_16x16x32_bf16 v[20:23], v[144:147], v[152:155], v[20:23]
    v_exp_f32 v198, -v246
    v_mfma_f32_16x16x32_bf16 v[20:23], v[108:111], v[176:179], v[20:23]
    v_exp_f32 v199, -v247
    v_mfma_f32_16x16x32_bf16 v[20:23], v[156:159], v[148:151], v[20:23]
    v_fma_f32 v196, v196, s32, s32
    v_fma_f32 v197, v197, s32, s32
    v_mfma_f32_16x16x32_bf16 v[20:23], v[172:175], v[180:183], v[20:23]
    v_fma_f32 v198, v198, s32, s32
    v_fma_f32 v199, v199, s32, s32
    v_mfma_f32_16x16x32_bf16 v[20:23], v[220:223], v[192:195], v[20:23]
    v_rcp_f32 v196, v196
    v_mfma_f32_16x16x32_bf16 v[24:27], v[124:127], v[152:155], v[24:27]
    v_rcp_f32 v197, v197
    v_mfma_f32_16x16x32_bf16 v[24:27], v[68:71], v[176:179], v[24:27]
    v_rcp_f32 v198, v198
    v_mfma_f32_16x16x32_bf16 v[24:27], v[120:123], v[160:163], v[24:27]
    v_rcp_f32 v199, v199
    v_mfma_f32_16x16x32_bf16 v[24:27], v[136:139], v[180:183], v[24:27]
    v_mul_f32 v244, v244, v196
    v_mul_f32 v245, v245, v197
    v_mfma_f32_16x16x32_bf16 v[24:27], v[168:171], v[192:195], v[24:27]
    v_mul_f32 v246, v246, v198
    v_mul_f32 v247, v247, v199
    v_mfma_f32_16x16x32_bf16 v[24:27], v[140:143], v[188:191], v[24:27]
    v_cvt_pk_bf16_f32 v218, v244, v245
    v_cvt_pk_bf16_f32 v219, v246, v247
    v_mfma_f32_16x16x32_bf16 v[28:31], v[128:131], v[152:155], v[28:31]
    ds_write_b64 v46, v[218:219] offset:0
    v_mfma_f32_16x16x32_bf16 v[28:31], v[144:147], v[176:179], v[28:31]
    ds_read_b128 v[204:207], v47 offset:0
    v_fma_f32 v240, v8, v224, v228
    v_mfma_f32_16x16x32_bf16 v[28:31], v[108:111], v[160:163], v[28:31]
    v_fma_f32 v241, v9, v225, v229
    v_fma_f32 v242, v10, v226, v230
    v_mfma_f32_16x16x32_bf16 v[28:31], v[156:159], v[180:183], v[28:31]
    v_fma_f32 v243, v11, v227, v231
    v_mfma_f32_16x16x32_bf16 v[28:31], v[172:175], v[192:195], v[28:31]
    v_exp_f32 v52, -v240
    v_mfma_f32_16x16x32_bf16 v[28:31], v[220:223], v[188:191], v[28:31]
    v_exp_f32 v53, -v241
    v_exp_f32 v54, -v242
    v_exp_f32 v55, -v243
    v_pk_fma_f32 v[52:53], v[52:53], s[32:33], s[32:33]
    v_pk_fma_f32 v[54:55], v[54:55], s[32:33], s[32:33]
    v_rcp_f32 v52, v52
    s_waitcnt lgkmcnt(0)
    global_store_dwordx4 v44, v[204:207], s[16:17] offset:0 sc0 sc1 nt
    v_rcp_f32 v53, v53
    v_rcp_f32 v54, v54
    v_rcp_f32 v55, v55
    v_pk_mul_f32 v[240:241], v[240:241], v[52:53]
    v_pk_mul_f32 v[242:243], v[242:243], v[54:55]
    v_cvt_pk_bf16_f32 v200, v240, v241
    v_cvt_pk_bf16_f32 v201, v242, v243
    v_pk_fma_f32 v[76:77], v[12:13], v[232:233], v[236:237]
    v_pk_fma_f32 v[78:79], v[14:15], v[234:235], v[238:239]
    ds_write_b64 v45, v[200:201] offset:1024
    v_exp_f32 v208, -v76
    v_exp_f32 v209, -v77
    v_exp_f32 v210, -v78
    v_exp_f32 v211, -v79
    v_pk_fma_f32 v[208:209], v[208:209], s[32:33], s[32:33]
    v_pk_fma_f32 v[210:211], v[210:211], s[32:33], s[32:33]
    v_rcp_f32 v208, v208
    v_rcp_f32 v209, v209
    v_rcp_f32 v210, v210
    v_rcp_f32 v211, v211
    v_pk_mul_f32 v[76:77], v[76:77], v[208:209]
    v_pk_mul_f32 v[78:79], v[78:79], v[210:211]
    v_cvt_pk_bf16_f32 v202, v76, v77
    v_cvt_pk_bf16_f32 v203, v78, v79
    v_pk_fma_f32 v[72:73], v[16:17], v[224:225], v[228:229]
    v_pk_fma_f32 v[74:75], v[18:19], v[226:227], v[230:231]
    ds_write_b64 v46, v[202:203] offset:1024
    ds_read_b128 v[104:107], v47 offset:1024
    v_exp_f32 v56, -v72
    v_exp_f32 v57, -v73
    v_exp_f32 v58, -v74
    v_exp_f32 v59, -v75
    v_pk_fma_f32 v[56:57], v[56:57], s[32:33], s[32:33]
    v_pk_fma_f32 v[58:59], v[58:59], s[32:33], s[32:33]
    v_rcp_f32 v56, v56
    v_rcp_f32 v57, v57
    v_rcp_f32 v58, v58
    v_rcp_f32 v59, v59
    v_pk_mul_f32 v[72:73], v[72:73], v[56:57]
    v_pk_mul_f32 v[74:75], v[74:75], v[58:59]
    v_cvt_pk_bf16_f32 v212, v72, v73
    v_cvt_pk_bf16_f32 v213, v74, v75
    v_pk_fma_f32 v[84:85], v[20:21], v[232:233], v[236:237]
    v_pk_fma_f32 v[86:87], v[22:23], v[234:235], v[238:239]
    s_waitcnt lgkmcnt(0)
    global_store_dwordx4 v44, v[104:107], s[16:17] offset:896 sc0 sc1 nt
    ds_write_b64 v45, v[212:213] offset:2048
    v_exp_f32 v88, -v84
    v_exp_f32 v89, -v85
    v_exp_f32 v90, -v86
    v_exp_f32 v91, -v87
    v_pk_fma_f32 v[88:89], v[88:89], s[32:33], s[32:33]
    v_pk_fma_f32 v[90:91], v[90:91], s[32:33], s[32:33]
    v_rcp_f32 v88, v88
    v_rcp_f32 v89, v89
    v_rcp_f32 v90, v90
    v_rcp_f32 v91, v91
    v_pk_mul_f32 v[84:85], v[84:85], v[88:89]
    v_pk_mul_f32 v[86:87], v[86:87], v[90:91]
    v_cvt_pk_bf16_f32 v214, v84, v85
    v_cvt_pk_bf16_f32 v215, v86, v87
    v_pk_fma_f32 v[80:81], v[24:25], v[224:225], v[228:229]
    v_pk_fma_f32 v[82:83], v[26:27], v[226:227], v[230:231]
    ds_write_b64 v46, v[214:215] offset:2048
    ds_read_b128 v[116:119], v47 offset:2048
    v_exp_f32 v64, -v80
    v_exp_f32 v65, -v81
    v_exp_f32 v66, -v82
    v_exp_f32 v67, -v83
    v_pk_fma_f32 v[64:65], v[64:65], s[32:33], s[32:33]
    v_pk_fma_f32 v[66:67], v[66:67], s[32:33], s[32:33]
    v_rcp_f32 v64, v64
    v_rcp_f32 v65, v65
    v_rcp_f32 v66, v66
    v_rcp_f32 v67, v67
    v_pk_mul_f32 v[80:81], v[80:81], v[64:65]
    v_pk_mul_f32 v[82:83], v[82:83], v[66:67]
    v_cvt_pk_bf16_f32 v96, v80, v81
    v_cvt_pk_bf16_f32 v97, v82, v83
    v_pk_fma_f32 v[100:101], v[28:29], v[232:233], v[236:237]
    v_pk_fma_f32 v[102:103], v[30:31], v[234:235], v[238:239]
    s_waitcnt lgkmcnt(0)
    global_store_dwordx4 v44, v[116:119], s[16:17] offset:1792 sc0 sc1 nt
    ds_write_b64 v45, v[96:97] offset:3072
    v_exp_f32 v60, -v100
    v_exp_f32 v61, -v101
    v_exp_f32 v62, -v102
    v_exp_f32 v63, -v103
    v_pk_fma_f32 v[60:61], v[60:61], s[32:33], s[32:33]
    v_pk_fma_f32 v[62:63], v[62:63], s[32:33], s[32:33]
    v_rcp_f32 v60, v60
    v_rcp_f32 v61, v61
    v_rcp_f32 v62, v62
    v_rcp_f32 v63, v63
    v_pk_mul_f32 v[100:101], v[100:101], v[60:61]
    v_pk_mul_f32 v[102:103], v[102:103], v[62:63]
    v_cvt_pk_bf16_f32 v98, v100, v101
    v_cvt_pk_bf16_f32 v99, v102, v103
    ds_write_b64 v46, v[98:99] offset:3072
    ds_read_b128 v[92:95], v47 offset:3072
    s_waitcnt lgkmcnt(0)
    global_store_dwordx4 v44, v[92:95], s[16:17] offset:2688 sc0 sc1 nt
L_end:
    s_endpgm
.section .rodata,"a"
.p2align 6
.amdhsa_kernel standalone__batchnorm__prompt_kernel
  .amdhsa_next_free_vgpr 256
  .amdhsa_next_free_sgpr 102
  .amdhsa_accum_offset 256
  .amdhsa_group_segment_fixed_size 0
  .amdhsa_kernarg_size 72
  .amdhsa_user_sgpr_count 2
  .amdhsa_user_sgpr_kernarg_segment_ptr 1
  .amdhsa_system_sgpr_workgroup_id_x 1
.end_amdhsa_kernel
```
